```python
import torch

def _softmax(x, axis=-1):
    return torch.softmax(x, dim=axis)
def _gelu(x):
    return torch.nn.functional.gelu(x, approximate="tanh")
def _silu(x):
    return torch.nn.functional.silu(x)
def _sigmoid(x):
    return torch.sigmoid(x)
def _layernorm(x, axis=-1, eps=1e-5):
    m = x.mean(dim=axis, keepdim=True)
    v = x.var(dim=axis, keepdim=True, unbiased=False)
    return (x - m) / torch.sqrt(v + eps)
def _scatter_add(tgt, idx, src, axis=0):
    return tgt.clone().index_add_(axis, idx, src)
def _segment_sum(src, seg, n):
    out = torch.zeros((n,) + src.shape[1:], dtype=src.dtype)
    return out.index_add_(0, seg, src)
def _pad(x, pw):
    flat = tuple(v for pair in reversed(pw) for v in pair)
    return torch.nn.functional.pad(x, flat)

kernel_name = 'standalone__linear_kernel_rfa__decode'

def setup_inputs():

    _w = (lambda a: (lambda t: t.to(torch.bfloat16) if t.is_floating_point() else t)(torch.as_tensor(a)))
    B, H, Sq, Sk, D, M = 1, 16, 1, 32768, 256, 8
    return {
        "q": _w((lambda *s: torch.randn(*s, dtype=torch.bfloat16) * 0.4)(B, H, Sq, D)),
        "k": _w((lambda *s: torch.randn(*s, dtype=torch.bfloat16) * 1.6)(B, H, Sk, D)),
        "v": _w((lambda *s: torch.randn(*s, dtype=torch.bfloat16) * 1.6)(B, H, Sk, D)),
        "omega": _w((lambda *s: torch.randn(*s, dtype=torch.bfloat16) * 1.6)(M, D)),
    }

def reference(q, k, v, omega):
    d = q.shape[-1]
    m = omega.shape[0]
    scale = float(d) ** -0.25
    qs = q * scale
    ks = k * scale
    q_proj = torch.einsum("bhsd,md->bhsm", qs, omega)
    k_proj = torch.einsum("bhsd,md->bhsm", ks, omega)
    q_sq = 0.5 * torch.einsum("bhsd,bhsd->bhs", qs, qs)[..., None]
    k_sq = 0.5 * torch.einsum("bhsd,bhsd->bhs", ks, ks)[..., None]
    inv_sqrt_m = float(m) ** -0.5
    phi_q = torch.exp(q_proj - q_sq) * inv_sqrt_m + 1e-6
    phi_k = torch.exp(k_proj - k_sq) * inv_sqrt_m + 1e-6
    kv = torch.einsum("bhsm,bhsd->bhmd", phi_k, v)
    z  = torch.einsum("bhsm->bhm", phi_k)
    num = torch.einsum("bhqm,bhmd->bhqd", phi_q, kv)
    den = torch.einsum("bhqm,bhm->bhq", phi_q, z)[..., None] + 1e-6
    return num / den
```

```asm
; @launch grid=(256,1,1) block=(320,1,1) lds=33280
.amdgcn_target "amdgcn-amd-amdhsa--gfx950"
.text
.globl standalone__linear_kernel_rfa__decode_kernel
.p2align 8
.type standalone__linear_kernel_rfa__decode_kernel,@function
standalone__linear_kernel_rfa__decode_kernel:
    s_cmp_ge_u32 s2, 256
    s_cbranch_scc1 L_done
    s_load_dwordx8 s[56:63], s[0:1], 0
    s_load_dwordx4 s[64:67], s[0:1], 40
    s_load_dwordx2 s[6:7], s[0:1], 32
    v_lshrrev_b32 v1, 6, v0
    v_and_b32 v0, 63, v0
    v_readfirstlane_b32 s3, v1
    s_lshr_b32 s28, s2, 4
    s_and_b32 s29, s2, 15
    s_lshl_b32 s31, s28, 24
    s_and_b32 s30, s2, 7
    s_lshl_b32 s30, s30, 21
    s_add_u32 s30, s30, s31
    s_and_b32 s41, s2, 8
    s_lshl_b32 s41, s41, 10
    s_add_u32 s30, s30, s41
    s_and_b32 s45, s3, 1
    s_lshl_b32 s45, s45, 9
    s_bfe_u32 s46, s3, 0x10001
    s_lshl_b32 s46, s46, 12
    s_add_u32 s30, s30, s45
    s_add_u32 s30, s30, s46
    s_mov_b32 s44, s30
    s_lshl_b32 s41, s28, 9
    v_lshrrev_b32 v22, 4, v0
    v_and_b32 v23, 1, v0
    v_lshl_add_u32 v23, v22, 1, v23
    v_lshlrev_b32 v24, 4, v23
    v_bfe_u32 v25, v0, 1, 1
    v_lshl_add_u32 v1, v25, 10, v24
    v_bfe_u32 v25, v0, 2, 1
    v_lshl_add_u32 v1, v25, 11, v1
    v_bfe_u32 v25, v0, 3, 1
    v_lshl_add_u32 v1, v25, 15, v1
    v_add_u32 v60, 65536, v1
    v_and_b32 v23, 1, v0
    v_bfe_u32 v25, v0, 2, 2
    v_lshl_add_u32 v23, v23, 2, v25
    v_lshlrev_b32 v23, 9, v23
    v_bfe_u32 v25, v0, 1, 1
    v_lshl_add_u32 v25, v22, 1, v25
    v_lshl_add_u32 v23, v25, 4, v23
    s_mov_b32 s10, 0x10000000
    s_mov_b32 s11, 0x20000
    s_mov_b32 s26, 4096
    s_mov_b32 s27, 0x20000
    s_mov_b32 s22, 8192
    s_mov_b32 s23, 0x20000
    s_cmp_eq_u32 s3, 4
    s_cbranch_scc1 L_help
    s_waitcnt lgkmcnt(0)
    s_mov_b32 s8, s58
    s_and_b32 s9, s59, 0xffff
    s_mov_b32 s24, s62
    s_and_b32 s25, s63, 0xffff
    buffer_load_dwordx4 v[32:35], v23, s[24:27], 0 offen offset:0
    buffer_load_dwordx4 v[36:39], v23, s[24:27], 0 offen offset:128
    buffer_load_dwordx4 v[40:43], v23, s[24:27], 0 offen offset:256
    buffer_load_dwordx4 v[44:47], v23, s[24:27], 0 offen offset:384
    buffer_load_dwordx4 v[84:87], v1, s[8:11], s44 offen offset:0 nt
    buffer_load_dwordx4 v[88:91], v1, s[8:11], s44 offen offset:128 nt
    buffer_load_dwordx4 v[92:95], v1, s[8:11], s44 offen offset:256 nt
    buffer_load_dwordx4 v[96:99], v1, s[8:11], s44 offen offset:384 nt
    buffer_load_dwordx4 v[100:103], v60, s[8:11], s44 offen offset:0 nt
    buffer_load_dwordx4 v[104:107], v60, s[8:11], s44 offen offset:128 nt
    buffer_load_dwordx4 v[108:111], v60, s[8:11], s44 offen offset:256 nt
    buffer_load_dwordx4 v[112:115], v60, s[8:11], s44 offen offset:384 nt
    v_cmp_eq_u32 vcc, 0, v0
    v_mov_b32 v3, 0x7ff00000
    v_mov_b32 v26, 0
    v_cndmask_b32 v3, v3, 0, vcc
    s_mov_b32 s36, 0xcccccccc
    s_mov_b32 s37, 0xcccccccc
    s_mov_b32 s42, 0xaaaaaaaa
    s_mov_b32 s43, 0xaaaaaaaa
    v_mov_b32 v4, 1.0
    v_mov_b32 v7, 5120
    v_lshlrev_b32 v63, 2, v0
    s_add_u32 s68, s66, 393216
    s_addc_u32 s69, s67, 0
    s_and_b32 s69, s69, 0xffff
    s_mov_b32 s70, 0
    s_mov_b32 s71, 0x20000
    s_lshr_b32 s58, s2, 3
    s_xor_b32 s58, s58, s2
    s_and_b32 s58, s58, 1
    s_lshl_b32 s59, s58, 13
    s_add_u32 s31, s31, s59
    s_add_u32 s31, s31, s45
    s_add_u32 s31, s31, s46
    s_lshl_b32 s58, s58, 2
    s_add_u32 s58, s58, s3
    s_lshl_b32 s34, s28, 3
    s_add_u32 s34, s34, s58
    s_lshl_b32 s47, s34, 13
    s_lshl_b32 s34, s34, 8
    s_mov_b32 s32, 1
    s_mov_b32 s53, 0
    s_mov_b32 s54, 0
    s_mov_b32 s33, 25
    s_mov_b32 s4, 3
    s_mov_b32 s55, 0
    s_mov_b32 s51, 0
    s_mov_b32 s78, 0
    s_mov_b32 s79, 0
    s_mov_b32 s20, s66
    s_and_b32 s21, s67, 0xffff
    s_mov_b32 s22, 0
    s_mov_b32 s35, 0x10000
    s_mov_b32 s12, s60
    s_and_b32 s13, s61, 0xffff
    s_mov_b32 s14, 0x10000000
    s_mov_b32 s15, 0x20000
    s_mov_b32 s48, 0
    v_mov_b32 v80, 0
    v_and_b32 v25, 15, v0
    v_lshlrev_b32 v25, 4, v25
    v_bfe_u32 v27, v0, 4, 1
    v_lshl_add_u32 v25, v27, 11, v25
    v_lshrrev_b32 v27, 5, v0
    v_lshl_add_u32 v2, v27, 15, v25
    v_add_u32 v61, 65536, v2
    s_mul_i32 s58, s3, 6912
    s_add_u32 s58, s58, 5632
    v_add_u32 v30, s58, v63
    v_and_b32 v25, 3, v0
    v_lshl_add_u32 v25, v22, 2, v25
    v_lshlrev_b32 v62, 2, v25
    v_mov_b32 v5, 0
    v_bfe_u32 v25, v0, 2, 2
    v_lshl_add_u32 v116, v25, 6, v62
    v_mov_b32 v117, 0
    v_mov_b32 v118, 0
    v_and_b32 v25, 0x33, v0
    v_lshlrev_b32 v119, 2, v25
    s_mov_b32 s76, 0x000f000f
    s_mov_b32 s77, 0x000f000f
    s_mov_b32 s49, 1
    s_mov_b32 s52, 1
    s_mov_b64 s[92:93], 0
    s_mov_b64 s[94:95], 0
    s_mov_b32 s96, 0
    s_mov_b64 s[98:99], -1
    s_mov_b32 s38, 0xff00ff00
    s_mov_b32 s39, 0xff00ff00
    v_and_b32 v22, 1, v0
    v_lshlrev_b32 v22, 4, v22
    v_mov_b32 v23, 0xffff
    v_lshlrev_b32 v22, v22, v23
    v_bfe_u32 v23, v0, 1, 2
    v_cmp_eq_u32 vcc, 0, v23
    v_mov_b32 v48, 0
    v_mov_b32 v49, 0
    v_cndmask_b32 v56, 0, v22, vcc
    v_cmp_eq_u32 vcc, 1, v23
    v_mov_b32 v50, 0
    v_mov_b32 v51, 0
    v_cndmask_b32 v57, 0, v22, vcc
    v_cmp_eq_u32 vcc, 2, v23
    v_mov_b32 v52, 0
    v_mov_b32 v53, 0
    v_cndmask_b32 v58, 0, v22, vcc
    v_cmp_eq_u32 vcc, 3, v23
    v_mov_b32 v54, 0
    v_mov_b32 v55, 0
    v_cndmask_b32 v59, 0, v22, vcc
    v_and_b32 v18, 15, v0
    v_lshlrev_b32 v18, 5, v18
    v_bfe_u32 v19, v0, 4, 1
    v_lshl_add_u32 v18, v19, 4, v18
    v_lshrrev_b32 v19, 5, v0
    v_lshl_add_u32 v18, v19, 9, v18
    s_lshl_b32 s58, s3, 10
    v_add_u32 v83, s58, v18
    s_waitcnt vmcnt(0)
.p2align 6
L_k:
    s_bfe_u32 s5, s51, 0x20006
    s_lshl_b32 s5, s5, 2
    s_lshl_b64 s[90:91], s[76:77], s5
    s_cmp_lg_u32 s52, 0
    s_cselect_b64 s[92:93], 0, s[92:93]
    s_or_b64 s[92:93], s[92:93], s[90:91]
    s_mov_b32 s52, s49
    s_andn2_b32 s100, s51, 255
    s_add_u32 s100, s100, s47
    s_min_u32 s101, s54, 26
    s_lshl_b32 s101, s101, 8
    s_waitcnt vmcnt(9)
    v_readfirstlane_b32 s58, v80
    v_add_u32 v29, s101, v30
    s_lshl_b32 s59, s58, 2
    s_lshl_b32 s5, s58, 1
    s_add_u32 s5, s5, 12
    s_add_u32 s50, s58, 26
    s_cmp_lt_u32 s58, 14
    s_cselect_b32 s50, s5, s50
    s_cselect_b32 s5, 1, 0
    s_cmp_lt_u32 s58, 6
    s_cselect_b32 s50, s59, s50
    s_cselect_b32 s5, 3, s5
    s_add_u32 s79, s79, 1
    s_sub_u32 s59, s78, 1
    s_cselect_b32 s79, s50, s79
    s_cselect_b32 s59, s5, s59
    s_cmp_lt_u32 s32, 26
    s_cselect_b32 s78, 0, s59
    s_lshl_b32 s58, s79, 6
    s_mul_i32 s5, s79, 10923
    s_lshr_b32 s5, s5, 16
    s_mul_i32 s50, s5, 6
    s_sub_u32 s59, s79, s50
    s_add_u32 s59, s59, 26
    s_and_b32 s50, s5, 1
    s_lshl_b32 s50, s50, 13
    s_xor_b32 s50, s50, s31
    s_lshl_b32 s5, s5, 21
    s_add_u32 s50, s50, s5
    s_cmp_lt_u32 s32, 26
    s_cselect_b32 s59, s32, s59
    s_cselect_b32 s50, s30, s50
    s_cselect_b32 s58, 0, s58
    s_and_b32 s5, s59, 1
    s_lshl_b32 s5, s5, 14
    s_lshr_b32 s59, s59, 1
    s_lshl_b32 s59, s59, 17
    s_add_u32 s5, s5, s50
    s_add_u32 s44, s5, s59
    s_cmp_ge_u32 s32, 25
    s_cselect_b32 s22, s35, 0
    s_cmp_eq_u32 s78, 0
    s_cselect_b32 s22, s22, 0
    s_cselect_b32 s49, 1, 0
    s_mov_b32 s51, s58
    s_add_u32 s32, s32, 1
    v_mov_b32 v80, 1
    s_cmp_ge_u32 s58, 3072
    s_waitcnt vmcnt(1)
    v_mfma_f32_16x16x32_bf16 v[8:11], v[84:87], v[32:35], 0
    v_mfma_f32_16x16x32_bf16 v[12:15], v[100:103], v[32:35], 0
    v_dot2_f32_bf16 v20, v84, v84, 0
    v_dot2_f32_bf16 v21, v100, v100, 0
    v_dot2_f32_bf16 v20, v85, v85, v20
    v_dot2_f32_bf16 v21, v101, v101, v21
    v_dot2_f32_bf16 v20, v86, v86, v20
    v_dot2_f32_bf16 v21, v102, v102, v21
    v_dot2_f32_bf16 v20, v87, v87, v20
    v_dot2_f32_bf16 v21, v103, v103, v21
    v_mfma_f32_16x16x32_bf16 v[8:11], v[88:91], v[36:39], v[8:11]
    v_mfma_f32_16x16x32_bf16 v[12:15], v[104:107], v[36:39], v[12:15]
    v_dot2_f32_bf16 v20, v88, v88, v20
    v_dot2_f32_bf16 v21, v104, v104, v21
    v_dot2_f32_bf16 v20, v89, v89, v20
    v_dot2_f32_bf16 v21, v105, v105, v21
    v_dot2_f32_bf16 v20, v90, v90, v20
    v_dot2_f32_bf16 v21, v106, v106, v21
    v_dot2_f32_bf16 v20, v91, v91, v20
    v_dot2_f32_bf16 v21, v107, v107, v21
    v_mfma_f32_16x16x32_bf16 v[8:11], v[92:95], v[40:43], v[8:11]
    v_mfma_f32_16x16x32_bf16 v[12:15], v[108:111], v[40:43], v[12:15]
    v_dot2_f32_bf16 v20, v92, v92, v20
    v_dot2_f32_bf16 v21, v108, v108, v21
    v_dot2_f32_bf16 v20, v93, v93, v20
    v_dot2_f32_bf16 v21, v109, v109, v21
    v_dot2_f32_bf16 v20, v94, v94, v20
    v_dot2_f32_bf16 v21, v110, v110, v21
    v_dot2_f32_bf16 v20, v95, v95, v20
    v_dot2_f32_bf16 v21, v111, v111, v21
    v_mfma_f32_16x16x32_bf16 v[8:11], v[96:99], v[44:47], v[8:11]
    v_mfma_f32_16x16x32_bf16 v[12:15], v[112:115], v[44:47], v[12:15]
    v_dot2_f32_bf16 v20, v96, v96, v20
    v_dot2_f32_bf16 v21, v112, v112, v21
    v_dot2_f32_bf16 v20, v97, v97, v20
    v_dot2_f32_bf16 v21, v113, v113, v21
    v_dot2_f32_bf16 v20, v98, v98, v20
    v_dot2_f32_bf16 v21, v114, v114, v21
    v_dot2_f32_bf16 v20, v99, v99, v20
    v_dot2_f32_bf16 v21, v115, v115, v21
    s_cbranch_scc1 L_kv
    buffer_atomic_add v80, v3, s[20:23], s34 offen sc0 sc1
    buffer_load_dwordx4 v[84:87], v1, s[8:11], s44 offen offset:0 nt
    buffer_load_dwordx4 v[88:91], v1, s[8:11], s44 offen offset:128 nt
    buffer_load_dwordx4 v[92:95], v1, s[8:11], s44 offen offset:256 nt
    buffer_load_dwordx4 v[96:99], v1, s[8:11], s44 offen offset:384 nt
    buffer_load_dwordx4 v[100:103], v60, s[8:11], s44 offen offset:0 nt
    buffer_load_dwordx4 v[104:107], v60, s[8:11], s44 offen offset:128 nt
    buffer_load_dwordx4 v[108:111], v60, s[8:11], s44 offen offset:256 nt
    buffer_load_dwordx4 v[112:115], v60, s[8:11], s44 offen offset:384 nt
L_kb:
    v_cndmask_b32 v24, v21, v20, s[42:43]
    v_cndmask_b32 v25, v20, v21, s[42:43]
    v_cndmask_b32 v26, v10, v9, s[36:37]
    s_nop 0
    v_add_f32_dpp v25, v24, v25 quad_perm:[1,0,3,2] row_mask:0xf bank_mask:0xf
    v_cndmask_b32 v27, v14, v13, s[36:37]
    v_cndmask_b32 v22, v8, v11, s[36:37]
    v_mfma_f32_16x16x4_f32 v[16:19], v25, v4, 0
    v_cndmask_b32 v23, v12, v15, s[36:37]
    v_add_f32_dpp v22, v26, v22 quad_perm:[2,3,0,1] row_mask:0xf bank_mask:0xf
    s_nop 0
    v_add_f32_dpp v23, v27, v23 quad_perm:[2,3,0,1] row_mask:0xf bank_mask:0xf
    v_cvt_pk_bf16_f32 v22, v22, v23
    v_and_b32 v23, 0xffff0000, v22
    v_lshlrev_b32 v22, 16, v22
    s_nop 2
    v_cndmask_b32 v24, v16, v18, s[36:37]
    v_cndmask_b32 v25, v17, v19, s[36:37]
    v_cvt_pk_bf16_f32 v24, v24, v25
    v_and_b32 v25, 0xffff0000, v24
    v_lshlrev_b32 v24, 16, v24
    v_fmac_f32 v22, 0xbe000000, v24
    v_fmac_f32 v23, 0xbe000000, v25
    v_cvt_pk_bf16_f32 v22, v22, v23
    v_and_b32 v23, 0xffff0000, v22
    v_lshlrev_b32 v22, 16, v22
    v_mul_f32 v22, 0x3eb8aa3b, v22
    v_mul_f32 v23, 0x3eb8aa3b, v23
    v_exp_f32 v22, v22
    v_exp_f32 v23, v23
    s_nop 0
    v_cvt_pk_bf16_f32 v22, v22, v23
    v_and_b32 v23, 0xffff0000, v22
    v_lshlrev_b32 v22, 16, v22
    v_mul_f32 v22, 0x3eb504f3, v22
    v_mul_f32 v23, 0x3eb504f3, v23
    v_cvt_pk_bf16_f32 v22, v22, v23
    v_and_b32 v23, 0xffff0000, v22
    v_lshlrev_b32 v22, 16, v22
    v_add_f32 v22, 0x358637bd, v22
    v_add_f32 v23, 0x358637bd, v23
    v_cvt_pk_bf16_f32 v24, v22, v23
    v_and_b32 v23, 0xffff0000, v24
    v_lshlrev_b32 v22, 16, v24
    s_cmp_eq_u32 s54, 0
    s_cbranch_scc1 L_getq
L_gotq:
    v_mul_f32 v24, v22, v6
    v_mul_f32 v25, v23, v6
    v_add_f32 v5, v5, v22
    v_cndmask_b32 v26, v25, v24, s[42:43]
    v_cndmask_b32 v24, v24, v25, s[42:43]
    v_add_f32 v5, v5, v23
    s_cmp_ge_u32 s54, 26
    v_add_f32_dpp v24, v26, v24 quad_perm:[1,0,3,2] row_mask:0xf bank_mask:0xf
    s_cselect_b32 s70, 1048576, 0
    s_add_u32 s54, s54, 1
    v_add_f32_dpp v24, v24, v24 row_ror:4 row_mask:0xf bank_mask:0xf
    s_nop 1
    v_add_f32_dpp v24, v24, v24 row_ror:8 row_mask:0xf bank_mask:0xf
    ds_write_b32 v29, v24
    v_cndmask_b32 v117, v117, v24, s[90:91]
    s_cmp_lg_u32 s52, 0
    s_cselect_b32 s70, s70, 0
    s_mov_b64 exec, s[92:93]
    buffer_store_dword v117, v116, s[68:71], s100 offen sc1
    s_mov_b64 exec, -1
    s_cmp_lg_u32 s48, 0
    s_cbranch_scc1 L_v
    s_cmp_lt_u32 s32, s33
    s_cbranch_scc1 L_k
    s_mov_b32 s33, -1
    s_mov_b32 s59, 200000
L_chkK:
    ds_read_b32 v22, v7 offset:4
    s_waitcnt lgkmcnt(0)
    v_readfirstlane_b32 s58, v22
    s_nop 0
    s_cmp_lg_u32 s58, 0
    s_cbranch_scc1 L_k
    s_sub_u32 s59, s59, 1
    s_cbranch_scc1 L_k
    s_sleep 8
    s_branch L_chkK
L_getq:
    s_barrier
    ds_read_b32 v6, v63 offset:5376
    s_waitcnt lgkmcnt(0)
    s_branch L_gotq
L_kv:
    s_or_b32 s34, s34, 0x8000
    s_mov_b32 s48, 1
    s_mov_b32 s44, s30
    s_mov_b64 s[72:73], -1
    s_mov_b32 s70, 0
    s_mov_b32 s22, 0
    s_mov_b32 s59, 0
    v_mov_b32 v28, v30
    s_mov_b32 s53, 1
    v_mov_b32 v80, 1
    buffer_atomic_add v80, v3, s[20:23], s34 offen sc0 sc1
    s_mov_b64 exec, s[98:99]
    buffer_load_dword v82, v116, s[68:71], s59 offen sc1
    s_mov_b64 exec, -1
    ds_read_b32 v81, v28
    buffer_load_dwordx4 v[84:87], v2, s[12:15], s44 offen offset:0 nt
    buffer_load_dwordx4 v[88:91], v2, s[12:15], s44 offen offset:256 nt
    buffer_load_dwordx4 v[92:95], v2, s[12:15], s44 offen offset:1024 nt
    buffer_load_dwordx4 v[96:99], v2, s[12:15], s44 offen offset:1280 nt
    buffer_load_dwordx4 v[100:103], v61, s[12:15], s44 offen offset:0 nt
    buffer_load_dwordx4 v[104:107], v61, s[12:15], s44 offen offset:256 nt
    buffer_load_dwordx4 v[108:111], v61, s[12:15], s44 offen offset:1024 nt
    buffer_load_dwordx4 v[112:115], v61, s[12:15], s44 offen offset:1280 nt
    s_branch L_kb
.p2align 6
L_v:
    s_waitcnt vmcnt(8) lgkmcnt(0)
    v_cndmask_b32 v118, v118, v82, s[94:95]
    v_add_u32 v22, s96, v119
    ds_bpermute_b32 v22, v22, v118
    v_readfirstlane_b32 s58, v80
    s_waitcnt lgkmcnt(0)
    v_cndmask_b32 v22, v22, v81, s[72:73]
    v_cvt_pk_bf16_f32 v23, v22, v22
    v_and_b32 v24, 0xffff0000, v23
    v_sub_f32 v22, v22, v24
    v_cvt_pk_bf16_f32 v22, v22, v22
    v_cndmask_b32 v23, v23, v22, s[38:39]
    s_min_u32 s41, s53, 26
    s_lshl_b32 s59, s58, 2
    v_and_b32_dpp v64, v23, v56 quad_perm:[0,0,0,0] row_mask:0xf bank_mask:0xf
    s_lshl_b32 s5, s58, 1
    v_and_b32_dpp v65, v23, v57 quad_perm:[0,0,0,0] row_mask:0xf bank_mask:0xf
    s_add_u32 s5, s5, 12
    v_and_b32_dpp v66, v23, v58 quad_perm:[0,0,0,0] row_mask:0xf bank_mask:0xf
    s_add_u32 s50, s58, 26
    v_and_b32_dpp v67, v23, v59 quad_perm:[0,0,0,0] row_mask:0xf bank_mask:0xf
    s_cmp_lt_u32 s58, 14
    v_and_b32_dpp v68, v23, v56 quad_perm:[2,2,2,2] row_mask:0xf bank_mask:0xf
    s_cselect_b32 s50, s5, s50
    v_and_b32_dpp v69, v23, v57 quad_perm:[2,2,2,2] row_mask:0xf bank_mask:0xf
    s_cselect_b32 s5, 1, 0
    v_and_b32_dpp v70, v23, v58 quad_perm:[2,2,2,2] row_mask:0xf bank_mask:0xf
    s_cmp_lt_u32 s58, 6
    v_and_b32_dpp v71, v23, v59 quad_perm:[2,2,2,2] row_mask:0xf bank_mask:0xf
    s_cselect_b32 s50, s59, s50
    v_and_b32_dpp v72, v23, v56 quad_perm:[1,1,1,1] row_mask:0xf bank_mask:0xf
    s_cselect_b32 s5, 3, s5
    v_and_b32_dpp v73, v23, v57 quad_perm:[1,1,1,1] row_mask:0xf bank_mask:0xf
    s_add_u32 s79, s79, 1
    v_and_b32_dpp v74, v23, v58 quad_perm:[1,1,1,1] row_mask:0xf bank_mask:0xf
    s_sub_u32 s59, s78, 1
    v_and_b32_dpp v75, v23, v59 quad_perm:[1,1,1,1] row_mask:0xf bank_mask:0xf
    s_cselect_b32 s79, s50, s79
    v_and_b32_dpp v76, v23, v56 quad_perm:[3,3,3,3] row_mask:0xf bank_mask:0xf
    s_cselect_b32 s59, s5, s59
    v_and_b32_dpp v77, v23, v57 quad_perm:[3,3,3,3] row_mask:0xf bank_mask:0xf
    s_cselect_b64 s[94:95], -1, 0
    v_and_b32_dpp v78, v23, v58 quad_perm:[3,3,3,3] row_mask:0xf bank_mask:0xf
    s_cselect_b32 s97, 1048576, 0
    v_and_b32_dpp v79, v23, v59 quad_perm:[3,3,3,3] row_mask:0xf bank_mask:0xf
    s_cmp_lt_u32 s53, 26
    s_cselect_b32 s78, 0, s59
    s_lshl_b32 s58, s79, 6
    s_mul_i32 s5, s79, 10923
    s_lshr_b32 s5, s5, 16
    s_mul_i32 s50, s5, 6
    s_sub_u32 s59, s79, s50
    s_add_u32 s59, s59, 26
    s_and_b32 s50, s5, 1
    s_lshl_b32 s50, s50, 13
    s_xor_b32 s50, s50, s31
    s_lshl_b32 s5, s5, 21
    s_add_u32 s50, s50, s5
    s_cmp_lt_u32 s53, 26
    s_cselect_b32 s59, s53, s59
    s_cselect_b32 s50, s30, s50
    s_cselect_b32 s58, 0, s58
    s_cselect_b64 s[72:73], -1, 0
    s_cselect_b32 s70, 0, s97
    s_and_b32 s5, s59, 1
    s_lshl_b32 s5, s5, 14
    s_lshr_b32 s59, s59, 1
    s_lshl_b32 s59, s59, 17
    s_add_u32 s5, s5, s50
    s_add_u32 s44, s5, s59
    s_cmp_ge_u32 s53, 25
    s_cselect_b32 s22, s35, 0
    s_cmp_eq_u32 s78, 0
    s_cselect_b32 s22, s22, 0
    s_lshl_b32 s41, s41, 8
    s_bfe_u32 s96, s58, 0x20006
    s_add_u32 s98, s78, 1
    s_lshl_b32 s98, s98, 2
    s_lshl_b32 s99, s96, 2
    s_bfm_b32 s98, s98, s99
    s_mul_i32 s98, s98, 0x10001
    s_mov_b32 s99, s98
    s_lshl_b32 s96, s96, 4
    s_andn2_b32 s59, s58, 255
    s_add_u32 s59, s59, s47
    v_add_u32 v28, s41, v30
    s_add_u32 s53, s53, 1
    s_cmp_ge_u32 s58, 3072
    s_waitcnt vmcnt(4)
    v_mfma_f32_16x16x32_bf16 v[48:51], v[64:67], v[84:87], v[48:51]
    v_mfma_f32_16x16x32_bf16 v[52:55], v[64:67], v[88:91], v[52:55]
    v_mfma_f32_16x16x32_bf16 v[48:51], v[68:71], v[92:95], v[48:51]
    v_mfma_f32_16x16x32_bf16 v[52:55], v[68:71], v[96:99], v[52:55]
    s_cbranch_scc1 L_last
    v_mov_b32 v80, 1
    buffer_atomic_add v80, v3, s[20:23], s34 offen sc0 sc1
    s_mov_b64 exec, s[98:99]
    buffer_load_dword v82, v116, s[68:71], s59 offen sc1
    s_mov_b64 exec, -1
    ds_read_b32 v81, v28
    buffer_load_dwordx4 v[84:87], v2, s[12:15], s44 offen offset:0 nt
    buffer_load_dwordx4 v[88:91], v2, s[12:15], s44 offen offset:256 nt
    buffer_load_dwordx4 v[92:95], v2, s[12:15], s44 offen offset:1024 nt
    buffer_load_dwordx4 v[96:99], v2, s[12:15], s44 offen offset:1280 nt
    s_waitcnt vmcnt(6)
    v_mfma_f32_16x16x32_bf16 v[48:51], v[72:75], v[100:103], v[48:51]
    v_mfma_f32_16x16x32_bf16 v[52:55], v[72:75], v[104:107], v[52:55]
    v_mfma_f32_16x16x32_bf16 v[48:51], v[76:79], v[108:111], v[48:51]
    v_mfma_f32_16x16x32_bf16 v[52:55], v[76:79], v[112:115], v[52:55]
    buffer_load_dwordx4 v[100:103], v61, s[12:15], s44 offen offset:0 nt
    buffer_load_dwordx4 v[104:107], v61, s[12:15], s44 offen offset:256 nt
    buffer_load_dwordx4 v[108:111], v61, s[12:15], s44 offen offset:1024 nt
    buffer_load_dwordx4 v[112:115], v61, s[12:15], s44 offen offset:1280 nt
    s_cmp_lt_u32 s53, s4
    s_cbranch_scc1 L_v
    s_cmp_lg_u32 s55, 0
    s_cbranch_scc1 L_ev6
    s_mov_b32 s55, 1
    s_mov_b32 s4, 26
    s_lshl_b32 s58, s3, 8
    v_add_u32 v22, s58, v63
    v_mov_b32 v23, 1
    ds_write_b32 v22, v5 offset:4096
    s_mov_b64 exec, 1
    ds_add_u32 v7, v23
    s_mov_b64 exec, -1
    s_branch L_v
L_ev6:
    s_mov_b32 s4, -1
    s_mov_b32 s59, 200000
L_chkV:
    ds_read_b32 v22, v7 offset:8
    s_waitcnt lgkmcnt(0)
    v_readfirstlane_b32 s58, v22
    s_nop 0
    s_cmp_lg_u32 s58, 0
    s_cbranch_scc1 L_v
    s_sub_u32 s59, s59, 1
    s_cbranch_scc1 L_v
    s_sleep 8
    s_branch L_chkV
L_last:
    s_waitcnt vmcnt(0)
    v_mfma_f32_16x16x32_bf16 v[48:51], v[72:75], v[100:103], v[48:51]
    v_mfma_f32_16x16x32_bf16 v[52:55], v[72:75], v[104:107], v[52:55]
    v_mfma_f32_16x16x32_bf16 v[48:51], v[76:79], v[108:111], v[48:51]
    v_mfma_f32_16x16x32_bf16 v[52:55], v[76:79], v[112:115], v[52:55]
    s_nop 7
    v_permlane32_swap_b32 v48, v52
    v_permlane32_swap_b32 v49, v53
    v_permlane32_swap_b32 v50, v54
    v_permlane32_swap_b32 v51, v55
    v_pk_add_f32 v[48:49], v[48:49], v[52:53]
    v_pk_add_f32 v[50:51], v[50:51], v[54:55]
    ds_write_b128 v83, v[48:51] offset:0
    s_waitcnt lgkmcnt(0)
    s_barrier
    s_endpgm
L_help:
    v_cmp_eq_u32 vcc, 0, v0
    v_mov_b32 v3, 0x7ff00000
    v_mov_b32 v26, 0
    v_cndmask_b32 v3, v3, 0, vcc
    s_mov_b32 s36, 0xcccccccc
    s_mov_b32 s37, 0xcccccccc
    s_mov_b32 s42, 0xaaaaaaaa
    s_mov_b32 s43, 0xaaaaaaaa
    v_mov_b32 v4, 1.0
    v_mov_b32 v7, 5120
    v_lshlrev_b32 v63, 2, v0
    v_mov_b32 v27, 0
    v_mov_b32 v28, 0
    v_mov_b32 v29, 0
    ds_write_b128 v7, v[26:29]
    s_waitcnt lgkmcnt(0)
    s_mov_b32 s24, s62
    s_and_b32 s25, s63, 0xffff
    buffer_load_dwordx4 v[32:35], v23, s[24:27], 0 offen offset:0
    buffer_load_dwordx4 v[36:39], v23, s[24:27], 0 offen offset:128
    buffer_load_dwordx4 v[40:43], v23, s[24:27], 0 offen offset:256
    buffer_load_dwordx4 v[44:47], v23, s[24:27], 0 offen offset:384
    s_mov_b32 s20, s56
    s_and_b32 s21, s57, 0xffff
    buffer_load_dwordx4 v[64:67], v24, s[20:23], s41 offen offset:0
    buffer_load_dwordx4 v[68:71], v24, s[20:23], s41 offen offset:128
    buffer_load_dwordx4 v[72:75], v24, s[20:23], s41 offen offset:256
    buffer_load_dwordx4 v[76:79], v24, s[20:23], s41 offen offset:384
    s_waitcnt vmcnt(0)
    v_mfma_f32_16x16x32_bf16 v[8:11], v[64:67], v[32:35], 0
    v_mfma_f32_16x16x32_bf16 v[12:15], v[64:67], v[32:35], 0
    v_dot2_f32_bf16 v20, v64, v64, 0
    v_dot2_f32_bf16 v21, v64, v64, 0
    v_dot2_f32_bf16 v20, v65, v65, v20
    v_dot2_f32_bf16 v21, v65, v65, v21
    v_dot2_f32_bf16 v20, v66, v66, v20
    v_dot2_f32_bf16 v21, v66, v66, v21
    v_dot2_f32_bf16 v20, v67, v67, v20
    v_dot2_f32_bf16 v21, v67, v67, v21
    v_mfma_f32_16x16x32_bf16 v[8:11], v[68:71], v[36:39], v[8:11]
    v_mfma_f32_16x16x32_bf16 v[12:15], v[68:71], v[36:39], v[12:15]
    v_dot2_f32_bf16 v20, v68, v68, v20
    v_dot2_f32_bf16 v21, v68, v68, v21
    v_dot2_f32_bf16 v20, v69, v69, v20
    v_dot2_f32_bf16 v21, v69, v69, v21
    v_dot2_f32_bf16 v20, v70, v70, v20
    v_dot2_f32_bf16 v21, v70, v70, v21
    v_dot2_f32_bf16 v20, v71, v71, v20
    v_dot2_f32_bf16 v21, v71, v71, v21
    v_mfma_f32_16x16x32_bf16 v[8:11], v[72:75], v[40:43], v[8:11]
    v_mfma_f32_16x16x32_bf16 v[12:15], v[72:75], v[40:43], v[12:15]
    v_dot2_f32_bf16 v20, v72, v72, v20
    v_dot2_f32_bf16 v21, v72, v72, v21
    v_dot2_f32_bf16 v20, v73, v73, v20
    v_dot2_f32_bf16 v21, v73, v73, v21
    v_dot2_f32_bf16 v20, v74, v74, v20
    v_dot2_f32_bf16 v21, v74, v74, v21
    v_dot2_f32_bf16 v20, v75, v75, v20
    v_dot2_f32_bf16 v21, v75, v75, v21
    v_mfma_f32_16x16x32_bf16 v[8:11], v[76:79], v[44:47], v[8:11]
    v_mfma_f32_16x16x32_bf16 v[12:15], v[76:79], v[44:47], v[12:15]
    v_dot2_f32_bf16 v20, v76, v76, v20
    v_dot2_f32_bf16 v21, v76, v76, v21
    v_dot2_f32_bf16 v20, v77, v77, v20
    v_dot2_f32_bf16 v21, v77, v77, v21
    v_dot2_f32_bf16 v20, v78, v78, v20
    v_dot2_f32_bf16 v21, v78, v78, v21
    v_dot2_f32_bf16 v20, v79, v79, v20
    v_dot2_f32_bf16 v21, v79, v79, v21
    s_nop 2
    v_cndmask_b32 v24, v21, v20, s[42:43]
    v_cndmask_b32 v25, v20, v21, s[42:43]
    v_cndmask_b32 v26, v10, v9, s[36:37]
    s_nop 0
    v_add_f32_dpp v25, v24, v25 quad_perm:[1,0,3,2] row_mask:0xf bank_mask:0xf
    v_cndmask_b32 v27, v14, v13, s[36:37]
    v_cndmask_b32 v22, v8, v11, s[36:37]
    v_mfma_f32_16x16x4_f32 v[16:19], v25, v4, 0
    v_cndmask_b32 v23, v12, v15, s[36:37]
    v_add_f32_dpp v22, v26, v22 quad_perm:[2,3,0,1] row_mask:0xf bank_mask:0xf
    s_nop 0
    v_add_f32_dpp v23, v27, v23 quad_perm:[2,3,0,1] row_mask:0xf bank_mask:0xf
    v_cvt_pk_bf16_f32 v22, v22, v23
    v_and_b32 v23, 0xffff0000, v22
    v_lshlrev_b32 v22, 16, v22
    s_nop 2
    v_cndmask_b32 v24, v16, v18, s[36:37]
    v_cndmask_b32 v25, v17, v19, s[36:37]
    v_cvt_pk_bf16_f32 v24, v24, v25
    v_and_b32 v25, 0xffff0000, v24
    v_lshlrev_b32 v24, 16, v24
    v_fmac_f32 v22, 0xbe000000, v24
    v_fmac_f32 v23, 0xbe000000, v25
    v_cvt_pk_bf16_f32 v22, v22, v23
    v_and_b32 v23, 0xffff0000, v22
    v_lshlrev_b32 v22, 16, v22
    v_mul_f32 v22, 0x3eb8aa3b, v22
    v_mul_f32 v23, 0x3eb8aa3b, v23
    v_exp_f32 v22, v22
    v_exp_f32 v23, v23
    s_nop 0
    v_cvt_pk_bf16_f32 v22, v22, v23
    v_and_b32 v23, 0xffff0000, v22
    v_lshlrev_b32 v22, 16, v22
    v_mul_f32 v22, 0x3eb504f3, v22
    v_mul_f32 v23, 0x3eb504f3, v23
    v_cvt_pk_bf16_f32 v22, v22, v23
    v_and_b32 v23, 0xffff0000, v22
    v_lshlrev_b32 v22, 16, v22
    v_add_f32 v22, 0x358637bd, v22
    v_add_f32 v23, 0x358637bd, v23
    v_cvt_pk_bf16_f32 v24, v22, v23
    v_and_b32 v23, 0xffff0000, v24
    v_lshlrev_b32 v22, 16, v24
    ds_write_b32 v63, v22 offset:5376
    s_waitcnt lgkmcnt(0)
    s_barrier
    v_and_b32 v24, 1, v0
    v_lshlrev_b32 v24, 1, v24
    v_lshrrev_b32 v25, 5, v0
    v_add_u32 v24, v24, v25
    v_bfe_u32 v25, v0, 1, 1
    v_lshl_add_u32 v24, v24, 2, v25
    v_lshlrev_b32 v24, 2, v24
    ds_bpermute_b32 v6, v24, v22
    s_mov_b32 s16, s66
    s_and_b32 s17, s67, 0xffff
    s_mov_b32 s18, 360448
    s_mov_b32 s19, 0x20000
    s_lshl_b32 s38, s2, 10
    s_add_u32 s38, s38, 65536
    s_lshl_b32 s40, s2, 7
    s_add_u32 s40, s40, 327680
    v_lshlrev_b32 v31, 4, v0
    s_mov_b32 s24, s64
    s_and_b32 s25, s65, 0xffff
    s_mov_b32 s26, 256
    s_lshl_b32 s41, s28, 4
    v_mov_b32 v25, 1
    v_mov_b32 v26, 0
    v_mov_b32 v27, 0x7ff00000
    s_cmp_lg_u32 s29, 0
    s_cbranch_scc1 L_noinit
    v_mov_b32 v84, -1
    v_mov_b32 v85, -1
    v_mov_b32 v86, -1
    v_mov_b32 v87, -1
    s_mov_b32 s58, s38
    buffer_store_dwordx4 v[84:87], v31, s[16:19], s58 offen offset:0 sc1
    buffer_store_dwordx4 v[84:87], v31, s[16:19], s58 offen offset:1024 sc1
    buffer_store_dwordx4 v[84:87], v31, s[16:19], s58 offen offset:2048 sc1
    buffer_store_dwordx4 v[84:87], v31, s[16:19], s58 offen offset:3072 sc1
    s_add_u32 s58, s58, 4096
    buffer_store_dwordx4 v[84:87], v31, s[16:19], s58 offen offset:0 sc1
    buffer_store_dwordx4 v[84:87], v31, s[16:19], s58 offen offset:1024 sc1
    buffer_store_dwordx4 v[84:87], v31, s[16:19], s58 offen offset:2048 sc1
    buffer_store_dwordx4 v[84:87], v31, s[16:19], s58 offen offset:3072 sc1
    s_add_u32 s58, s58, 4096
    buffer_store_dwordx4 v[84:87], v31, s[16:19], s58 offen offset:0 sc1
    buffer_store_dwordx4 v[84:87], v31, s[16:19], s58 offen offset:1024 sc1
    buffer_store_dwordx4 v[84:87], v31, s[16:19], s58 offen offset:2048 sc1
    buffer_store_dwordx4 v[84:87], v31, s[16:19], s58 offen offset:3072 sc1
    s_add_u32 s58, s58, 4096
    buffer_store_dwordx4 v[84:87], v31, s[16:19], s58 offen offset:0 sc1
    buffer_store_dwordx4 v[84:87], v31, s[16:19], s58 offen offset:1024 sc1
    buffer_store_dwordx4 v[84:87], v31, s[16:19], s58 offen offset:2048 sc1
    buffer_store_dwordx4 v[84:87], v31, s[16:19], s58 offen offset:3072 sc1
    v_lshrrev_b32 v28, 1, v0
    v_lshlrev_b32 v28, 7, v28
    v_and_b32 v29, 1, v0
    v_lshl_add_u32 v28, v29, 4, v28
    v_cmp_gt_u32 vcc, 32, v0
    s_lshl_b32 s58, s28, 11
    s_nop 0
    v_cndmask_b32 v28, v27, v28, vcc
    buffer_store_dwordx4 v[84:87], v28, s[16:19], s40 offen sc1
    v_and_b32 v28, 7, v0
    v_lshlrev_b32 v28, 8, v28
    v_bfe_u32 v29, v0, 3, 1
    v_lshl_add_u32 v28, v29, 15, v28
    v_cmp_gt_u32 vcc, 16, v0
    s_nop 1
    v_cndmask_b32 v28, v27, v28, vcc
    buffer_store_dword v26, v28, s[16:19], s58 offen sc1
    s_waitcnt vmcnt(0)
    buffer_store_dword v25, v3, s[24:27], s41 offen sc1
L_noinit:
    s_mov_b32 s59, 200000
    s_sleep 127
    buffer_load_dword v22, v3, s[24:27], s41 offen
L_fpK:
    s_waitcnt vmcnt(0)
    v_readfirstlane_b32 s58, v22
    s_nop 0
    s_cmp_lg_u32 s58, 0
    s_cbranch_scc1 L_fqK
    s_sub_u32 s59, s59, 1
    s_cbranch_scc1 L_fqK
    s_sleep 127
    buffer_load_dword v22, v3, s[24:27], s41 offen sc1
    s_branch L_fpK
L_fqK:
    ds_write_b32 v7, v25 offset:4
    s_lshl_b32 s46, s28, 14
    s_lshl_b32 s59, s29, 6
    s_add_u32 s46, s46, s59
    s_add_u32 s46, s46, 65536
    s_lshl_b32 s42, s28, 11
    s_add_u32 s42, s42, 327680
    v_lshrrev_b32 v19, 2, v0
    v_and_b32 v20, 3, v0
    v_lshlrev_b32 v18, 4, v20
    v_lshl_add_u32 v18, v19, 10, v18
    v_lshlrev_b32 v19, 7, v19
    v_lshl_add_u32 v19, v20, 3, v19
    s_mov_b32 s24, s6
    s_and_b32 s25, s7, 0xffff
    s_mov_b32 s26, 8192
    s_lshl_b32 s43, s2, 5
    v_lshlrev_b32 v20, 2, v20
    v_bfe_u32 v21, v0, 4, 1
    v_lshl_add_u32 v20, v21, 1, v20
    v_lshrrev_b32 v21, 5, v0
    v_add_u32 v20, v20, v21
    v_lshlrev_b32 v20, 1, v20
    v_and_b32 v21, 12, v0
    v_cmp_eq_u32 vcc, 0, v21
    v_and_b32 v28, 1, v0
    v_bfe_u32 v29, v0, 2, 2
    v_cndmask_b32 v20, v27, v20, vcc
    v_lshl_add_u32 v28, v28, 2, v29
    v_lshlrev_b32 v28, 2, v28
    v_and_b32 v29, 0x32, v0
    v_cmp_eq_u32 vcc, 0, v29
    s_mov_b32 s59, 200000
    s_nop 0
    v_cndmask_b32 v21, v27, v28, vcc
L_kd:
    s_sleep 32
    ds_read_b32 v22, v7
    s_waitcnt lgkmcnt(0)
    v_readfirstlane_b32 s58, v22
    s_nop 0
    s_cmp_eq_u32 s58, 4
    s_cbranch_scc1 L_ke
    s_sub_u32 s59, s59, 1
    s_cbranch_scc0 L_kd
L_ke:
    ds_read_b32 v8, v63 offset:4096
    ds_read_b32 v9, v63 offset:4352
    ds_read_b32 v10, v63 offset:4608
    ds_read_b32 v11, v63 offset:4864
    s_waitcnt lgkmcnt(0)
    v_add_f32 v8, v8, v9
    v_add_f32 v10, v10, v11
    v_add_f32 v8, v8, v10
    s_nop 1
    v_add_f32_dpp v8, v8, v8 quad_perm:[2,3,0,1] row_mask:0xf bank_mask:0xf
    v_mov_b32 v9, v8
    s_nop 1
    v_permlane16_swap_b32 v8, v9
    v_add_f32 v8, v8, v9
    v_mov_b32 v9, v8
    s_nop 1
    v_permlane32_swap_b32 v8, v9
    v_add_f32 v8, v8, v9
    v_min_u32 v8, -2, v8
    buffer_store_dword v8, v21, s[16:19], s40 offen sc1
    s_mov_b32 s59, 200000
L_fpV:
    s_sleep 127
    buffer_load_dwordx2 v[88:89], v19, s[16:19], s42 offen sc1
    s_waitcnt vmcnt(0)
    v_max_u32 v9, v88, v89
    v_cmp_eq_u32 vcc, -1, v9
    s_nop 0
    s_cmp_eq_u64 vcc, 0
    s_cbranch_scc1 L_fqV
    s_sub_u32 s59, s59, 1
    s_cbranch_scc0 L_fpV
L_fqV:
    ds_write_b32 v7, v25 offset:8
    v_permlane32_swap_b32 v88, v89
    v_add_f32 v88, v88, v89
    v_mov_b32 v89, v88
    s_nop 1
    v_permlane16_swap_b32 v88, v89
    v_add_f32 v88, v88, v89
    s_nop 1
    v_add_f32_dpp v88, v88, v88 row_ror:4 row_mask:0xf bank_mask:0xf
    s_nop 1
    v_add_f32_dpp v88, v88, v88 row_ror:8 row_mask:0xf bank_mask:0xf
    v_cvt_pk_bf16_f32 v88, v88, v88
    v_lshlrev_b32 v88, 16, v88
    v_mul_f32 v88, v88, v6
    s_nop 1
    v_add_f32_dpp v88, v88, v88 quad_perm:[1,0,3,2] row_mask:0xf bank_mask:0xf
    s_nop 1
    v_add_f32_dpp v88, v88, v88 quad_perm:[2,3,0,1] row_mask:0xf bank_mask:0xf
    v_mov_b32 v89, v88
    s_nop 1
    v_permlane32_swap_b32 v88, v89
    v_add_f32 v88, v88, v89
    v_cvt_pk_bf16_f32 v88, v88, v88
    v_and_b32 v88, 0xffff0000, v88
    v_add_f32 v88, 0x358637bd, v88
    v_cvt_pk_bf16_f32 v88, v88, v88
    v_and_b32 v88, 0xffff0000, v88
    s_mov_b32 s41, 200000
    s_mov_b64 s[60:61], -1
    s_waitcnt lgkmcnt(0)
    s_barrier
    ds_read_b128 v[32:35], v31 offset:0
    ds_read_b128 v[36:39], v31 offset:1024
    ds_read_b128 v[40:43], v31 offset:2048
    ds_read_b128 v[44:47], v31 offset:3072
    s_waitcnt lgkmcnt(2)
    v_pk_add_f32 v[32:33], v[32:33], v[36:37]
    v_pk_add_f32 v[34:35], v[34:35], v[38:39]
    s_waitcnt lgkmcnt(0)
    v_pk_add_f32 v[40:41], v[40:41], v[44:45]
    v_pk_add_f32 v[42:43], v[42:43], v[46:47]
    v_pk_add_f32 v[32:33], v[32:33], v[40:41]
    v_pk_add_f32 v[34:35], v[34:35], v[42:43]
    v_min_u32 v32, -2, v32
    v_min_u32 v33, -2, v33
    v_min_u32 v34, -2, v34
    v_min_u32 v35, -2, v35
    buffer_store_dwordx4 v[32:35], v31, s[16:19], s38 offen sc1
    buffer_load_dwordx4 v[84:87], v18, s[16:19], s46 offen sc1
    s_sleep 8
L_poll:
    s_mov_b64 exec, s[60:61]
    buffer_load_dwordx4 v[84:87], v18, s[16:19], s46 offen sc1
    s_mov_b64 exec, -1
    s_waitcnt vmcnt(1)
    v_max3_u32 v8, v84, v85, v86
    v_max_u32 v8, v8, v87
    v_cmp_eq_u32 s[60:61], -1, v8
    s_nop 0
    s_cmp_eq_u64 s[60:61], 0
    s_cbranch_scc1 L_ready
    s_sub_u32 s41, s41, 1
    s_cbranch_scc0 L_poll
L_ready:
    v_mov_b32 v92, v84
    v_mov_b32 v93, v85
    v_mov_b32 v94, v86
    v_mov_b32 v95, v87
    v_permlane32_swap_b32 v92, v93
    s_nop 0
    v_permlane32_swap_b32 v94, v95
    v_add_f32 v92, v92, v93
    v_add_f32 v94, v94, v95
    s_nop 1
    v_permlane16_swap_b32 v92, v94
    v_add_f32 v92, v92, v94
    s_nop 1
    v_add_f32_dpp v92, v92, v92 row_ror:4 row_mask:0xf bank_mask:0xf
    s_nop 1
    v_add_f32_dpp v92, v92, v92 row_ror:8 row_mask:0xf bank_mask:0xf
    v_cvt_pk_bf16_f32 v92, v92, v92
    v_and_b32 v92, 0xffff0000, v92
    v_div_scale_f32 v8, s[56:57], v88, v88, v92
    v_rcp_f32 v9, v8
    v_div_scale_f32 v10, vcc, v92, v88, v92
    v_fma_f32 v11, -v8, v9, 1.0
    v_fmac_f32 v9, v11, v9
    v_mul_f32 v11, v10, v9
    v_fma_f32 v12, -v8, v11, v10
    v_fmac_f32 v11, v12, v9
    v_fma_f32 v8, -v8, v11, v10
    v_div_fmas_f32 v8, v8, v9, v11
    v_div_fixup_f32 v8, v8, v88, v92
    v_cvt_pk_bf16_f32 v8, v8, v8
    buffer_store_short v8, v20, s[24:27], s43 offen
L_done:
    s_endpgm
.section .rodata,"a"
.p2align 6
.amdhsa_kernel standalone__linear_kernel_rfa__decode_kernel
  .amdhsa_next_free_vgpr 120
  .amdhsa_next_free_sgpr 102
  .amdhsa_accum_offset 120
  .amdhsa_group_segment_fixed_size 0
  .amdhsa_kernarg_size 56
  .amdhsa_user_sgpr_count 2
  .amdhsa_user_sgpr_kernarg_segment_ptr 1
  .amdhsa_system_sgpr_workgroup_id_x 1
  .amdhsa_float_denorm_mode_32 3
.end_amdhsa_kernel
```
